```python
import torch

def _softmax(x, axis=-1):
    return torch.softmax(x, dim=axis)
def _gelu(x):
    return torch.nn.functional.gelu(x, approximate="tanh")
def _silu(x):
    return torch.nn.functional.silu(x)
def _sigmoid(x):
    return torch.sigmoid(x)
def _layernorm(x, axis=-1, eps=1e-5):
    m = x.mean(dim=axis, keepdim=True)
    v = x.var(dim=axis, keepdim=True, unbiased=False)
    return (x - m) / torch.sqrt(v + eps)
def _scatter_add(tgt, idx, src, axis=0):
    return tgt.clone().index_add_(axis, idx, src)
def _segment_sum(src, seg, n):
    out = torch.zeros((n,) + src.shape[1:], dtype=src.dtype)
    return out.index_add_(0, seg, src)
def _pad(x, pw):
    flat = tuple(v for pair in reversed(pw) for v in pair)
    return torch.nn.functional.pad(x, flat)

kernel_name = 'standalone__mpnn_edge_mlp__graph'

def setup_inputs():

    _w = (lambda a: (lambda t: t.to(torch.bfloat16) if t.is_floating_point() else t)(torch.as_tensor(a)))
    N, deg, D, De = 50000, 16, 64, max(16, 1)
    E = N * deg
    return {
        "x": _w((lambda *s: torch.randn(*s, dtype=torch.bfloat16) * 0.05)(N, D)),
        "e_attr": _w((lambda *s: torch.randn(*s, dtype=torch.bfloat16) * 0.4)(E, De)),
        "src": _w((lambda lo, hi, *s: torch.randint(lo, hi, s))(0, N, E).to(torch.int64)),
        "dst": _w((lambda lo, hi, *s: torch.randint(lo, hi, s))(0, N, E).to(torch.int64)),
        "w_msg": _w((lambda *s: torch.randn(*s, dtype=torch.bfloat16) * 0.4)(2 * D + De, D)),
        "w_upd": _w((lambda *s: torch.randn(*s, dtype=torch.bfloat16) * 0.05)(2 * D, D)),
    }

def reference(x, e_attr, src, dst, w_msg, w_upd):
    N, D = x.shape
    m_in = torch.concatenate([x[src], x[dst], e_attr], axis=-1)
    msg = _silu(m_in @ w_msg)
    agg = _segment_sum(msg, dst, N)
    return _silu(torch.concatenate([x, agg], axis=-1) @ w_upd)
```

```asm
; @launch kernel=k1_kernel grid=(253,1,1) block=(1024,1,1) lds=84000
; @launch kernel=k2_kernel grid=(256,1,1) block=(512,1,1) lds=157952
.amdgcn_target "amdgcn-amd-amdhsa--gfx950"
.text
.globl k1_kernel
.p2align 8
.type k1_kernel,@function
k1_kernel:
    s_cmp_ge_u32 s2, 253
    s_cbranch_scc1 K1_PF
    s_load_dwordx4 s[4:7], s[0:1], 8
    s_load_dwordx2 s[8:9], s[0:1], 24
    s_load_dwordx4 s[12:15], s[0:1], 32
    s_load_dwordx2 s[10:11], s[0:1], 64
    v_lshrrev_b32 v1, 6, v0
    v_and_b32 v2, 63, v0
    v_readfirstlane_b32 s3, v1
    s_cmp_ge_u32 s2, 250
    s_cbranch_scc1 K1_FRAG
    v_mov_b32 v6, 0
    v_lshlrev_b32 v7, 2, v0
    v_and_b32 v7, 0x7ff, v7
    ds_write_b32 v7, v6 offset:25600
    s_mul_i32 s40, s2, 12800
    s_mul_i32 s41, s2, 102400
    v_lshlrev_b32 v3, 4, v0
    s_movk_i32 s42, 256
    v_cmp_le_u32 s[52:53], s42, v0
    s_movk_i32 s42, 800
    v_cmp_gt_u32 vcc, s42, v0
    v_mov_b32 v5, 0x7ffffff0
    v_mov_b32 v35, 1024
    v_cndmask_b32 v4, v5, v3, vcc
    v_cndmask_b32 v35, v6, v35, s[52:53]
    s_waitcnt lgkmcnt(0)
    s_mov_b32 s24, s8
    s_mov_b32 s25, s9
    s_mov_b32 s26, 3200000
    s_mov_b32 s27, 0x00020000
    buffer_load_dwordx4 v[8:11], v4, s[24:27], s40 offen nt
    s_mov_b32 s20, s6
    s_mov_b32 s21, s7
    s_mov_b32 s22, 3200000
    s_mov_b32 s23, 0x00020000
    buffer_load_dwordx4 v[12:15], v4, s[20:23], s40 offen nt
    s_barrier
    s_mov_b32 s16, s4
    s_mov_b32 s17, s5
    s_mov_b32 s18, 25600000
    s_mov_b32 s19, 0x00020000
    s_lshl_b32 s43, s3, 10
    s_add_u32 m0, s43, 29696
    s_add_u32 s44, s41, 0
    buffer_load_dwordx4 v3, s[16:19], s44 offen nt lds
    s_add_u32 m0, s43, 46080
    s_add_u32 s44, s41, 16384
    buffer_load_dwordx4 v3, s[16:19], s44 offen nt lds
K1_DMADONE:
    s_add_u32 s28, s10, 0
    s_addc_u32 s29, s11, 0
    s_mov_b32 s30, 25600000
    s_mov_b32 s31, 0x00020000
    s_add_u32 s32, s10, 35651584
    s_addc_u32 s33, s11, 0
    s_mov_b32 s34, 6400000
    s_mov_b32 s35, 0x00020000
    s_add_u32 s36, s10, 29884416
    s_addc_u32 s37, s11, 0
    s_mov_b32 s38, 512000
    s_mov_b32 s39, 0x00020000
    s_lshl_b32 s54, s40, 1
    s_add_u32 s55, s54, 12800
    s_and_saveexec_b64 s[46:47], vcc
    s_cbranch_execz K1_NOHIST
    s_mov_b32 s45, 83887
    s_movk_i32 s48, 200
    v_mov_b32 v6, 1
    s_waitcnt vmcnt(2)
    v_mul_u32_u24 v16, s45, v8
    v_lshrrev_b32 v16, 24, v16
    v_mul_u32_u24 v20, s48, v16
    v_sub_u32 v20, v8, v20
    v_lshl_add_u32 v16, v16, 2, v35
    ds_add_rtn_u32 v28, v16, v6 offset:25600
    v_mul_u32_u24 v17, s45, v9
    v_lshrrev_b32 v17, 24, v17
    v_mul_u32_u24 v21, s48, v17
    v_sub_u32 v21, v9, v21
    v_lshl_add_u32 v17, v17, 2, v35
    ds_add_rtn_u32 v29, v17, v6 offset:25600
    v_mul_u32_u24 v18, s45, v10
    v_lshrrev_b32 v18, 24, v18
    v_mul_u32_u24 v22, s48, v18
    v_sub_u32 v22, v10, v22
    v_lshl_add_u32 v18, v18, 2, v35
    ds_add_rtn_u32 v30, v18, v6 offset:25600
    v_mul_u32_u24 v19, s45, v11
    v_lshrrev_b32 v19, 24, v19
    v_mul_u32_u24 v23, s48, v19
    v_sub_u32 v23, v11, v23
    v_lshl_add_u32 v19, v19, 2, v35
    ds_add_rtn_u32 v31, v19, v6 offset:25600
    v_mul_u32_u24 v24, 41, v20
    v_lshrrev_b32 v24, 10, v24
    v_mul_u32_u24 v8, 25, v24
    v_sub_u32 v8, v20, v8
    v_lshlrev_b32 v8, 19, v8
    v_lshl_or_b32 v8, v24, 24, v8
    v_or_b32 v56, v12, v8
    v_mul_u32_u24 v25, 41, v21
    v_lshrrev_b32 v25, 10, v25
    v_mul_u32_u24 v9, 25, v25
    v_sub_u32 v9, v21, v9
    v_lshlrev_b32 v9, 19, v9
    v_lshl_or_b32 v9, v25, 24, v9
    v_or_b32 v58, v13, v9
    v_mul_u32_u24 v26, 41, v22
    v_lshrrev_b32 v26, 10, v26
    v_mul_u32_u24 v10, 25, v26
    v_sub_u32 v10, v22, v10
    v_lshlrev_b32 v10, 19, v10
    v_lshl_or_b32 v10, v26, 24, v10
    v_or_b32 v60, v14, v10
    v_mul_u32_u24 v27, 41, v23
    v_lshrrev_b32 v27, 10, v27
    v_mul_u32_u24 v11, 25, v27
    v_sub_u32 v11, v23, v11
    v_lshlrev_b32 v11, 19, v11
    v_lshl_or_b32 v11, v27, 24, v11
    v_or_b32 v62, v15, v11
K1_NOHIST:
    s_mov_b64 exec, s[46:47]
    v_lshlrev_b32 v32, 5, v2
    s_waitcnt lgkmcnt(0)
    s_barrier
    ds_read_b128 v[36:39], v32 offset:25600
    ds_read_b128 v[40:43], v32 offset:25616
    s_movk_i32 s49, 27648
    v_add_u32 v33, s49, v32
    s_waitcnt lgkmcnt(0)
    v_add3_u32 v53, v36, v37, v38
    v_add3_u32 v54, v39, v40, v41
    v_add3_u32 v53, v53, v42, v43
    v_add_u32 v53, v53, v54
    v_mov_b32 v44, v53
    s_nop 1
    v_add_u32_dpp v44, v44, v44 row_shr:1 row_mask:0xf bank_mask:0xf bound_ctrl:0
    s_nop 1
    v_add_u32_dpp v44, v44, v44 row_shr:2 row_mask:0xf bank_mask:0xf bound_ctrl:0
    s_nop 1
    v_add_u32_dpp v44, v44, v44 row_shr:4 row_mask:0xf bank_mask:0xf bound_ctrl:0
    s_nop 1
    v_add_u32_dpp v44, v44, v44 row_shr:8 row_mask:0xf bank_mask:0xf bound_ctrl:0
    s_nop 1
    v_add_u32_dpp v44, v44, v44 row_bcast:15 row_mask:0xa bank_mask:0xf
    s_nop 1
    v_add_u32_dpp v44, v44, v44 row_bcast:31 row_mask:0xc bank_mask:0xf
    v_sub_u32 v44, v44, v53
    v_add_u32 v45, v44, v36
    v_add_u32 v46, v45, v37
    v_add_u32 v47, v46, v38
    v_add_u32 v48, v47, v39
    v_add_u32 v49, v48, v40
    v_add_u32 v50, v49, v41
    v_add_u32 v51, v50, v42
    ds_write_b128 v33, v[44:47]
    ds_write_b128 v33, v[48:51] offset:16
    s_and_saveexec_b64 s[46:47], vcc
    s_cbranch_execz K1_NOPOS
    v_add_u32 v16, s49, v16
    ds_read_b32 v20, v16
    v_add_u32 v17, s49, v17
    ds_read_b32 v21, v17
    v_add_u32 v18, s49, v18
    ds_read_b32 v22, v18
    v_add_u32 v19, s49, v19
    ds_read_b32 v23, v19
    v_lshlrev_b32 v34, 7, v0
    v_add_u32 v34, s41, v34
    s_waitcnt lgkmcnt(0)
    v_add_lshl_u32 v20, v20, v28, 3
    v_add_u32 v57, 0, v34
    ds_write_b64 v20, v[56:57]
    v_add_lshl_u32 v21, v21, v29, 3
    v_add_u32 v59, 32, v34
    ds_write_b64 v21, v[58:59]
    v_add_lshl_u32 v22, v22, v30, 3
    v_add_u32 v61, 64, v34
    ds_write_b64 v22, v[60:61]
    v_add_lshl_u32 v23, v23, v31, 3
    v_add_u32 v63, 96, v34
    ds_write_b64 v23, v[62:63]
K1_NOPOS:
    s_mov_b64 exec, s[46:47]
    s_waitcnt vmcnt(0) lgkmcnt(0)
    s_barrier
    s_cmp_lg_u32 s3, 15
    s_cbranch_scc1 K1_NOT
    v_lshl_or_b32 v36, v36, 16, v44
    v_lshl_or_b32 v37, v37, 16, v45
    v_lshl_or_b32 v38, v38, 16, v46
    v_lshl_or_b32 v39, v39, 16, v47
    v_lshl_or_b32 v40, v40, 16, v48
    v_lshl_or_b32 v41, v41, 16, v49
    v_lshl_or_b32 v42, v42, 16, v50
    v_lshl_or_b32 v43, v43, 16, v51
    s_lshl_b32 s50, s2, 11
    buffer_store_dwordx4 v[36:39], v32, s[36:39], s50 offen sc1
    buffer_store_dwordx4 v[40:43], v32, s[36:39], s50 offen offset:16 sc1
K1_NOT:
    ds_read_b128 v[8:11], v3 offset:0
    ds_read_b128 v[12:15], v3 offset:12800
    v_and_b32 v6, 0x3fe, v0
    v_lshlrev_b32 v6, 2, v6
    v_and_b32 v7, 1, v0
    v_lshlrev_b32 v7, 4, v7
    s_sub_u32 s45, 29696, s41
    v_add_u32 v7, s45, v7
    ds_read_b32 v16, v6 offset:4
    ds_read_b32 v17, v6 offset:4100
    s_waitcnt lgkmcnt(2)
    buffer_store_dwordx4 v[8:11], v4, s[32:35], s54 offen sc1
    buffer_store_dwordx4 v[12:15], v4, s[32:35], s55 offen sc1
    s_waitcnt lgkmcnt(0)
    v_add_u32 v16, v16, v7
    ds_read_b128 v[24:27], v16
    v_add_u32 v17, v17, v7
    ds_read_b128 v[28:31], v17
    s_add_u32 s44, s41, 0
    s_waitcnt lgkmcnt(1)
    buffer_store_dwordx4 v[24:27], v3, s[28:31], s44 offen sc1
    s_add_u32 s44, s41, 16384
    s_waitcnt lgkmcnt(0)
    buffer_store_dwordx4 v[28:31], v3, s[28:31], s44 offen sc1
K1_FIN:
    s_endpgm
K1_FRAG:
    s_sub_u32 s16, s2, 250
    s_lshl_b32 s16, s16, 4
    s_add_u32 s16, s16, s3
    s_cmp_ge_u32 s16, 36
    s_cbranch_scc1 K1_END
    s_waitcnt lgkmcnt(0)
    s_add_u32 s28, s10, 30408704
    s_addc_u32 s29, s11, 0
    s_mov_b32 s30, 36864
    s_mov_b32 s31, 0x00020000
    v_and_b32 v3, 31, v2
    v_lshrrev_b32 v4, 5, v2
    s_and_b32 s17, s16, 1
    s_lshr_b32 s18, s16, 1
    s_mov_b32 s19, 0xbfb8aa3b
    s_movk_i32 s20, 1024
    s_movk_i32 s21, 512
    s_cmp_ge_u32 s16, 20
    s_cbranch_scc1 K1_FU
    s_mov_b32 s24, s12
    s_mov_b32 s25, s13
    s_mov_b32 s26, 18432
    s_mov_b32 s27, 0x00020000
    s_lshl_b32 s22, s18, 4
    s_cmp_ge_u32 s18, 4
    s_cselect_b32 s22, 128, s22
    s_sub_u32 s23, s18, 6
    s_lshl_b32 s23, s23, 4
    s_add_u32 s23, s23, 64
    s_cmp_ge_u32 s18, 6
    s_cselect_b32 s22, s23, s22
    s_cselect_b32 s19, 1.0, s19
    s_lshl_b32 s23, s17, 5
    v_add_u32 v5, s23, v3
    s_branch K1_FGO
K1_FU:
    s_mov_b32 s24, s14
    s_mov_b32 s25, s15
    s_mov_b32 s26, 16384
    s_mov_b32 s27, 0x00020000
    s_mov_b32 s19, 1.0
    s_sub_u32 s22, s18, 10
    s_cmp_ge_u32 s22, 4
    s_cselect_b32 s20, 512, s20
    s_cselect_b32 s21, 1024, s21
    s_lshl_b32 s22, s22, 4
    v_bfe_u32 v5, v3, 2, 1
    v_lshlrev_b32 v5, 5, v5
    v_lshrrev_b32 v6, 3, v3
    v_lshl_add_u32 v5, v6, 2, v5
    v_and_b32 v6, 3, v3
    v_add_u32 v5, v5, v6
    s_lshl_b32 s23, s17, 4
    v_add_u32 v5, s23, v5
K1_FGO:
    s_lshl_b32 s22, s22, 7
    v_lshlrev_b32 v5, 1, v5
    v_mul_u32_u24 v6, s20, v4
    v_add3_u32 v5, v5, v6, s22
    v_add_u32 v6, s21, v5
    buffer_load_ushort v8, v5, s[24:27], 0 offen offset:0
    buffer_load_ushort v9, v5, s[24:27], 0 offen offset:128
    buffer_load_ushort v10, v5, s[24:27], 0 offen offset:256
    buffer_load_ushort v11, v5, s[24:27], 0 offen offset:384
    buffer_load_ushort v12, v6, s[24:27], 0 offen offset:0
    buffer_load_ushort v13, v6, s[24:27], 0 offen offset:128
    buffer_load_ushort v14, v6, s[24:27], 0 offen offset:256
    buffer_load_ushort v15, v6, s[24:27], 0 offen offset:384
    s_waitcnt vmcnt(0)
    v_lshlrev_b32 v8, 16, v8
    v_mul_f32 v8, s19, v8
    v_lshlrev_b32 v9, 16, v9
    v_mul_f32 v9, s19, v9
    v_lshlrev_b32 v10, 16, v10
    v_mul_f32 v10, s19, v10
    v_lshlrev_b32 v11, 16, v11
    v_mul_f32 v11, s19, v11
    v_lshlrev_b32 v12, 16, v12
    v_mul_f32 v12, s19, v12
    v_lshlrev_b32 v13, 16, v13
    v_mul_f32 v13, s19, v13
    v_lshlrev_b32 v14, 16, v14
    v_mul_f32 v14, s19, v14
    v_lshlrev_b32 v15, 16, v15
    v_mul_f32 v15, s19, v15
    v_cvt_pk_bf16_f32 v16, v8, v9
    v_cvt_pk_bf16_f32 v17, v10, v11
    v_cvt_pk_bf16_f32 v18, v12, v13
    v_cvt_pk_bf16_f32 v19, v14, v15
    s_cmp_lg_u32 s18, 5
    s_cbranch_scc1 K1_FST
    v_lshlrev_b32 v20, 16, v16
    v_and_b32 v21, 0xffff0000, v16
    v_sub_f32 v20, v8, v20
    v_sub_f32 v21, v9, v21
    v_cvt_pk_bf16_f32 v16, v20, v21
    v_lshlrev_b32 v20, 16, v17
    v_and_b32 v21, 0xffff0000, v17
    v_sub_f32 v20, v10, v20
    v_sub_f32 v21, v11, v21
    v_cvt_pk_bf16_f32 v17, v20, v21
    v_lshlrev_b32 v20, 16, v18
    v_and_b32 v21, 0xffff0000, v18
    v_sub_f32 v20, v12, v20
    v_sub_f32 v21, v13, v21
    v_cvt_pk_bf16_f32 v18, v20, v21
    v_lshlrev_b32 v20, 16, v19
    v_and_b32 v21, 0xffff0000, v19
    v_sub_f32 v20, v14, v20
    v_sub_f32 v21, v15, v21
    v_cvt_pk_bf16_f32 v19, v20, v21
K1_FST:
    v_lshlrev_b32 v7, 4, v2
    s_lshl_b32 s16, s16, 10
    buffer_store_dwordx4 v[16:19], v7, s[28:31], s16 offen
    s_endpgm
K1_PF:
K1_END:
    s_endpgm
.globl k2_kernel
.p2align 8
.type k2_kernel,@function
k2_kernel:
    s_and_b32 s3, s2, 7
    s_lshl_b32 s3, s3, 5
    s_lshr_b32 s4, s2, 3
    s_add_u32 s3, s3, s4
    s_cmp_ge_u32 s2, 256
    s_cbranch_scc1 K2_END
    s_cmp_ge_u32 s3, 250
    s_cbranch_scc1 K2_END
    s_load_dwordx2 s[4:5], s[0:1], 0
    s_load_dwordx2 s[8:9], s[0:1], 8
    s_load_dwordx2 s[6:7], s[0:1], 48
    s_load_dwordx2 s[10:11], s[0:1], 64
    v_lshrrev_b32 v32, 6, v0
    v_and_b32 v1, 63, v0
    v_readfirstlane_b32 s12, v32
    v_and_b32 v33, 255, v0
    v_lshlrev_b32 v34, 11, v33
    s_lshl_b32 s13, s3, 2
    s_cmp_lt_u32 s12, 4
    s_cselect_b32 s15, 1024, 0
    s_add_u32 s13, s13, s15
    v_and_b32 v35, 31, v1
    v_lshrrev_b32 v36, 5, v1
    v_lshlrev_b32 v37, 7, v35
    v_lshl_add_u32 v37, v36, 4, v37
    v_cmp_gt_u32 vcc, 25, v35
    v_mov_b32 v38, 0x7ffffff0
    s_nop 0
    v_cndmask_b32 v37, v38, v37, vcc
    v_lshlrev_b32 v38, 4, v1
    s_waitcnt lgkmcnt(0)
    s_add_u32 s64, s10, 29884416
    s_addc_u32 s65, s11, 0
    s_mov_b32 s66, 512000
    s_mov_b32 s67, 0x00020000
    buffer_load_dword v39, v34, s[64:67], s13 offen
    s_mov_b32 s16, s4
    s_mov_b32 s17, s5
    s_mov_b32 s18, 6400000
    s_mov_b32 s19, 0x00020000
    s_mov_b32 s20, s6
    s_mov_b32 s21, s7
    s_mov_b32 s22, 6400000
    s_mov_b32 s23, 0x00020000
    s_add_u32 s28, s10, 0
    s_addc_u32 s29, s11, 0
    s_mov_b32 s30, 25600000
    s_mov_b32 s31, 0x00020000
    s_add_u32 s32, s10, 35651584
    s_addc_u32 s33, s11, 0
    s_mov_b32 s34, 6400000
    s_mov_b32 s35, 0x00020000
    s_add_u32 s40, s10, 30408704
    s_addc_u32 s41, s11, 0
    s_mov_b32 s42, 36864
    s_mov_b32 s43, 0x00020000
    s_lshl_b32 s46, s12, 10
    s_add_u32 s57, s46, 100608
    s_add_u32 m0, s46, 51456
    s_add_u32 s45, s46, 0
    buffer_load_dwordx4 v38, s[40:43], s45 offen lds
    s_add_u32 m0, s46, 59648
    s_add_u32 s45, s46, 8192
    buffer_load_dwordx4 v38, s[40:43], s45 offen lds
    s_cmp_ge_u32 s12, 4
    s_cbranch_scc1 K2_WD
    s_add_u32 m0, s46, 67840
    s_add_u32 s45, s46, 16384
    buffer_load_dwordx4 v38, s[40:43], s45 offen lds
K2_WD:
    s_mov_b32 s36, s8
    s_mov_b32 s37, s9
    s_mov_b32 s38, 25600000
    s_mov_b32 s39, 0x00020000
    s_sub_u32 s24, s4, 4096
    s_subb_u32 s25, s5, 0
    s_mov_b32 s26, 6404096
    s_mov_b32 s27, 0x00020000
    s_movk_i32 s60, 128
    v_and_b32 v40, 7, v1
    v_lshrrev_b32 v41, 4, v1
    v_xor_b32 v40, v40, v41
    v_lshlrev_b32 v40, 4, v40
    v_xor_b32 v41, 64, v40
    v_add_u32 v2, 4096, v40
    v_add_u32 v3, 3072, v41
    v_add_u32 v4, 2048, v40
    v_add_u32 v13, 1024, v41
    s_lshl_b32 s44, s12, 12
    s_add_u32 s44, s44, 35072
    v_bfe_u32 v41, v1, 1, 3
    v_xor_b32 v41, v41, v36
    v_lshlrev_b32 v41, 4, v41
    v_lshlrev_b32 v40, 7, v35
    v_add_u32 v40, s44, v40
    v_xor_b32 v42, 0, v41
    v_add_u32 v5, v40, v42
    v_xor_b32 v42, 32, v41
    v_add_u32 v6, v40, v42
    v_xor_b32 v42, 64, v41
    v_add_u32 v7, v40, v42
    v_xor_b32 v42, 96, v41
    v_add_u32 v8, v40, v42
    v_lshlrev_b32 v71, 4, v36
    v_mul_u32_u24 v14, 264, v36
    v_add_u32 v14, 128, v14
    v_bfe_u32 v40, v1, 4, 1
    v_and_b32 v41, 3, v1
    v_lshl_add_u32 v40, v40, 2, v41
    v_mul_u32_u24 v15, 264, v40
    v_add_u32 v15, 128, v15
    v_bfe_u32 v40, v0, 5, 3
    v_lshlrev_b32 v41, 2, v40
    v_sub_u32 v41, v35, v41
    v_cmp_gt_u32 vcc, 4, v41
    v_mov_b32 v42, 0x3f80
    v_mov_b32 v43, 0
    v_cndmask_b32 v42, v43, v42, vcc
    v_lshlrev_b32 v41, 4, v41
    v_lshlrev_b64 v[42:43], v41, v[42:43]
    v_mul_u32_u24 v44, 264, v40
    v_lshl_add_u32 v44, v35, 3, v44
    ds_write_b64 v44, v[42:43] offset:128
    v_mov_b32 v44, 0
    v_mov_b32 v45, 0
    ds_write_b64 v44, v[44:45] offset:64
    s_mov_b32 s50, 0
    s_mov_b32 s59, 0
    s_movk_i32 s51, 2560
    s_movk_i32 s61, 1280
    s_mov_b32 s52, 1
K2_ROUND:
    v_lshlrev_b32 v40, 4, v0
    v_lshlrev_b32 v41, 3, v0
    v_mov_b32 v44, 0x00f8ffff
    v_mov_b32 v48, 0
    v_mov_b32 v52, 0x03ffffff
    v_mov_b32 v45, 0x00f8ffff
    v_mov_b32 v49, 0
    v_mov_b32 v53, 0x03ffffff
    v_mov_b32 v46, 0x00f8ffff
    v_mov_b32 v50, 0
    v_mov_b32 v54, 0x03ffffff
    v_mov_b32 v47, 0x00f8ffff
    v_mov_b32 v51, 0
    v_mov_b32 v55, 0x03ffffff
    ds_write_b128 v40, v[44:47] offset:2304
    ds_write_b128 v40, v[44:47] offset:10496
    ds_write_b128 v40, v[52:55] offset:18688
    ds_write_b128 v40, v[52:55] offset:26880
    ds_write_b128 v40, v[52:55] offset:35072
    ds_write_b128 v40, v[52:55] offset:43264
    ds_write_b128 v48, v[48:51] offset:0
    ds_write_b128 v48, v[48:51] offset:16
    ds_write_b128 v48, v[48:51] offset:32
    ds_write_b128 v48, v[48:51] offset:48
    s_waitcnt vmcnt(0) lgkmcnt(0)
    s_barrier
    s_cmp_eq_u32 s52, 0
    s_cbranch_scc1 K2_NOSCAN
    s_lshl_b32 s46, s12, 10
    s_mul_i32 s15, s3, 25600
    s_add_u32 s15, s15, s46
    v_add_u32 v40, s15, v38
    s_cmp_ge_u32 s12, 2
    s_cbranch_scc1 K2_XD
    s_add_u32 m0, s46, 96512
    v_add_u32 v41, 24576, v40
    buffer_load_dwordx4 v41, s[16:19], 0 offen lds
K2_XD:
    s_add_u32 m0, s46, 71936
    v_add_u32 v41, 0, v40
    buffer_load_dwordx4 v41, s[16:19], 0 offen lds
    s_add_u32 m0, s46, 80128
    v_add_u32 v41, 8192, v40
    buffer_load_dwordx4 v41, s[16:19], 0 offen lds
    s_add_u32 m0, s46, 88320
    v_add_u32 v41, 16384, v40
    buffer_load_dwordx4 v41, s[16:19], 0 offen lds
    s_add_u32 m0, s46, 141568
    s_add_u32 s45, s46, 20480
    buffer_load_dwordx4 v38, s[40:43], s45 offen lds
    s_add_u32 m0, s46, 149760
    s_add_u32 s45, s46, 28672
    buffer_load_dwordx4 v38, s[40:43], s45 offen lds
    v_lshrrev_b32 v17, 16, v39
    v_and_b32 v39, 0xffff, v39
    s_movk_i32 s46, 3200
    v_mad_u32_u24 v18, v33, s46, v39
    v_mov_b32 v41, v17
    s_nop 1
    v_add_u32_dpp v41, v41, v41 row_shr:1 row_mask:0xf bank_mask:0xf bound_ctrl:0
    s_nop 1
    v_add_u32_dpp v41, v41, v41 row_shr:2 row_mask:0xf bank_mask:0xf bound_ctrl:0
    s_nop 1
    v_add_u32_dpp v41, v41, v41 row_shr:4 row_mask:0xf bank_mask:0xf bound_ctrl:0
    s_nop 1
    v_add_u32_dpp v41, v41, v41 row_shr:8 row_mask:0xf bank_mask:0xf bound_ctrl:0
    s_nop 1
    v_add_u32_dpp v41, v41, v41 row_bcast:15 row_mask:0xa bank_mask:0xf
    s_nop 1
    v_add_u32_dpp v41, v41, v41 row_bcast:31 row_mask:0xc bank_mask:0xf
    s_and_b32 s47, s12, 4
    v_readlane_b32 s46, v41, 63
    s_mov_b64 exec, 1
    v_mov_b32 v43, s47
    v_mov_b32 v42, s46
    ds_add_rtn_u32 v42, v43, v42 offset:64
    s_waitcnt lgkmcnt(0)
    v_readfirstlane_b32 s46, v42
    s_mov_b64 exec, -1
    v_sub_u32 v16, v41, v17
    v_add_u32 v16, s46, v16
K2_NOSCAN:
    s_cmp_lt_u32 s12, 4
    s_cselect_b32 s46, s50, s59
    s_cselect_b32 s47, s51, s61
    s_cselect_b32 s48, 0, 10240
    v_sub_u32 v40, s46, v16
    v_add_u32 v41, s47, v40
    v_min_i32 v41, v41, v17
    v_max_i32 v42, 0, v40
    v_sub_u32 v43, v42, v40
    v_lshl_add_u32 v43, v43, 2, s48
    v_add_u32 v42, v42, v18
    v_add_u32 v41, v41, v18
K2_GL:
    v_cmpx_lt_i32 vcc, v42, v41
    ds_write_b32 v43, v42 offset:35072
    v_add_u32 v42, 1, v42
    v_cmpx_lt_i32 vcc, v42, v41
    ds_write_b32 v43, v42 offset:35076
    v_add_u32 v42, 1, v42
    v_cmpx_lt_i32 vcc, v42, v41
    ds_write_b32 v43, v42 offset:35080
    v_add_u32 v42, 1, v42
    v_cmpx_lt_i32 vcc, v42, v41
    ds_write_b32 v43, v42 offset:35084
    v_add_u32 v42, 1, v42
    v_cmpx_lt_i32 vcc, v42, v41
    ds_write_b32 v43, v42 offset:35088
    v_add_u32 v42, 1, v42
    v_cmpx_lt_i32 vcc, v42, v41
    ds_write_b32 v43, v42 offset:35092
    v_add_u32 v42, 1, v42
    v_cmpx_lt_i32 vcc, v42, v41
    ds_write_b32 v43, v42 offset:35096
    v_add_u32 v42, 1, v42
    v_cmpx_lt_i32 vcc, v42, v41
    ds_write_b32 v43, v42 offset:35100
    v_add_u32 v42, 1, v42
    v_add_u32 v43, 32, v43
    s_cbranch_execnz K2_GL
K2_GD:
    s_mov_b64 exec, -1
    s_waitcnt lgkmcnt(0)
    s_barrier
    v_lshlrev_b32 v40, 2, v0
    v_mov_b32 v41, 0
    ds_read_b32 v44, v40 offset:35072
    ds_read_b32 v45, v40 offset:37120
    ds_read_b32 v46, v40 offset:39168
    ds_read_b32 v47, v40 offset:41216
    ds_read_b32 v48, v40 offset:43264
    ds_read_b32 v49, v40 offset:45312
    ds_read_b32 v50, v40 offset:47360
    ds_read_b32 v51, v40 offset:49408
    ds_read_b64 v[54:55], v41 offset:64
    v_and_b32 v42, 0x1fe, v0
    v_lshlrev_b32 v42, 1, v42
    v_and_b32 v43, 1, v0
    v_lshlrev_b32 v43, 4, v43
    s_waitcnt lgkmcnt(0)
    ds_read_b32 v124, v42 offset:45312
    ds_read_b32 v125, v42 offset:46336
    ds_read_b32 v126, v42 offset:47360
    ds_read_b32 v127, v42 offset:48384
    ds_read_b32 v32, v42 offset:49408
    v_lshlrev_b32 v49, 3, v49
    buffer_load_dword v82, v49, s[32:35], 0 offen
    v_lshlrev_b32 v50, 3, v50
    buffer_load_dword v84, v50, s[32:35], 0 offen
    v_lshlrev_b32 v51, 3, v51
    buffer_load_dword v86, v51, s[32:35], 0 offen
    v_lshlrev_b32 v44, 3, v44
    buffer_load_dwordx2 v[72:73], v44, s[32:35], 0 offen
    v_lshlrev_b32 v45, 3, v45
    buffer_load_dwordx2 v[74:75], v45, s[32:35], 0 offen
    v_lshlrev_b32 v46, 3, v46
    buffer_load_dwordx2 v[76:77], v46, s[32:35], 0 offen
    v_lshlrev_b32 v47, 3, v47
    buffer_load_dwordx2 v[78:79], v47, s[32:35], 0 offen
    v_lshlrev_b32 v48, 3, v48
    buffer_load_dwordx2 v[80:81], v48, s[32:35], 0 offen
    v_readfirstlane_b32 s53, v54
    v_readfirstlane_b32 s62, v55
    s_waitcnt lgkmcnt(0)
    v_lshl_add_u32 v124, v124, 5, v43
    v_lshl_add_u32 v125, v125, 5, v43
    v_lshl_add_u32 v126, v126, 5, v43
    v_lshl_add_u32 v127, v127, 5, v43
    v_lshl_add_u32 v32, v32, 5, v43
    s_sub_i32 s54, s53, s50
    s_min_i32 s54, s54, s51
    s_sub_i32 s63, s62, s59
    s_min_i32 s63, s63, s61
    s_cmp_eq_u32 s52, 0
    s_cbranch_scc1 K2_NOW
    v_add_u32 v44, 51456, v38
    ds_read_b128 v[128:131], v44 offset:0
    ds_read_b128 v[132:135], v44 offset:1024
    ds_read_b128 v[136:139], v44 offset:2048
    ds_read_b128 v[140:143], v44 offset:3072
    ds_read_b128 v[144:147], v44 offset:4096
    ds_read_b128 v[148:151], v44 offset:5120
    ds_read_b128 v[152:155], v44 offset:6144
    ds_read_b128 v[156:159], v44 offset:7168
    ds_read_b128 v[160:163], v44 offset:8192
    ds_read_b128 v[164:167], v44 offset:9216
    ds_read_b128 v[192:195], v44 offset:12288
    ds_read_b128 v[196:199], v44 offset:13312
    ds_read_b128 v[200:203], v44 offset:14336
    ds_read_b128 v[204:207], v44 offset:15360
    ds_read_b128 v[208:211], v44 offset:16384
    ds_read_b128 v[212:215], v44 offset:17408
    ds_read_b128 v[216:219], v44 offset:18432
    ds_read_b128 v[220:223], v44 offset:19456
K2_NOW:
    v_mov_b32 v41, 1
    v_add_u32 v40, 0, v0
    v_cmp_gt_i32 s[64:65], s54, v40
    v_add_u32 v40, 512, v0
    v_cmp_gt_i32 s[66:67], s54, v40
    v_add_u32 v40, 1024, v0
    v_cmp_gt_i32 s[68:69], s54, v40
    v_add_u32 v40, 1536, v0
    v_cmp_gt_i32 s[70:71], s54, v40
    v_add_u32 v40, 2048, v0
    v_cmp_gt_i32 s[72:73], s54, v40
    v_add_u32 v40, 0, v0
    v_cmp_gt_i32 s[74:75], s63, v40
    v_lshlrev_b32 v40, 5, v40
    v_add_u32 v83, 0x80018900, v40
    v_add_u32 v40, 512, v0
    v_cmp_gt_i32 s[76:77], s63, v40
    v_lshlrev_b32 v40, 5, v40
    v_add_u32 v85, 0x80018900, v40
    v_add_u32 v40, 1024, v0
    v_cmp_gt_i32 s[78:79], s63, v40
    v_lshlrev_b32 v40, 5, v40
    v_add_u32 v87, 0x80018900, v40
    s_waitcnt vmcnt(7)
    v_lshrrev_b32 v93, 24, v82
    v_lshlrev_b32 v237, 2, v93
    s_mov_b64 exec, s[74:75]
    ds_add_rtn_u32 v229, v237, v41 offset:0
    s_mov_b64 exec, -1
    s_waitcnt vmcnt(6)
    v_lshrrev_b32 v94, 24, v84
    v_lshlrev_b32 v238, 2, v94
    s_mov_b64 exec, s[76:77]
    ds_add_rtn_u32 v230, v238, v41 offset:0
    s_mov_b64 exec, -1
    s_waitcnt vmcnt(5)
    v_lshrrev_b32 v95, 24, v86
    v_lshlrev_b32 v239, 2, v95
    s_mov_b64 exec, s[78:79]
    ds_add_rtn_u32 v231, v239, v41 offset:0
    s_mov_b64 exec, -1
    s_waitcnt vmcnt(4)
    v_lshrrev_b32 v88, 24, v72
    v_lshlrev_b32 v232, 2, v88
    s_mov_b64 exec, s[64:65]
    ds_add_rtn_u32 v224, v232, v41 offset:0
    s_mov_b64 exec, -1
    s_waitcnt vmcnt(3)
    v_lshrrev_b32 v89, 24, v74
    v_lshlrev_b32 v233, 2, v89
    s_mov_b64 exec, s[66:67]
    ds_add_rtn_u32 v225, v233, v41 offset:0
    s_mov_b64 exec, -1
    s_waitcnt vmcnt(2)
    v_lshrrev_b32 v90, 24, v76
    v_lshlrev_b32 v234, 2, v90
    s_mov_b64 exec, s[68:69]
    ds_add_rtn_u32 v226, v234, v41 offset:0
    s_mov_b64 exec, -1
    s_waitcnt vmcnt(1)
    v_lshrrev_b32 v91, 24, v78
    v_lshlrev_b32 v235, 2, v91
    s_mov_b64 exec, s[70:71]
    ds_add_rtn_u32 v227, v235, v41 offset:0
    s_mov_b64 exec, -1
    s_waitcnt vmcnt(0)
    v_lshrrev_b32 v92, 24, v80
    v_lshlrev_b32 v236, 2, v92
    s_mov_b64 exec, s[72:73]
    ds_add_rtn_u32 v228, v236, v41 offset:0
    s_mov_b64 exec, -1
    s_movk_i32 s46, 512
    s_waitcnt lgkmcnt(7)
    v_cmp_gt_u32 vcc, s46, v229
    v_lshl_add_u32 v229, v93, 9, v229
    v_lshlrev_b32 v237, 2, v229
    s_and_b64 exec, vcc, s[74:75]
    ds_write2st64_b32 v237, v82, v83 offset0:9 offset1:73
    s_mov_b64 exec, -1
    s_waitcnt lgkmcnt(7)
    v_cmp_gt_u32 vcc, s46, v230
    v_lshl_add_u32 v230, v94, 9, v230
    v_lshlrev_b32 v238, 2, v230
    s_and_b64 exec, vcc, s[76:77]
    ds_write2st64_b32 v238, v84, v85 offset0:9 offset1:73
    s_mov_b64 exec, -1
    s_waitcnt lgkmcnt(7)
    v_cmp_gt_u32 vcc, s46, v231
    v_lshl_add_u32 v231, v95, 9, v231
    v_lshlrev_b32 v239, 2, v231
    s_and_b64 exec, vcc, s[78:79]
    ds_write2st64_b32 v239, v86, v87 offset0:9 offset1:73
    s_mov_b64 exec, -1
    s_waitcnt lgkmcnt(7)
    v_cmp_gt_u32 vcc, s46, v224
    v_lshl_add_u32 v224, v88, 9, v224
    v_lshlrev_b32 v232, 2, v224
    s_and_b64 exec, vcc, s[64:65]
    ds_write2st64_b32 v232, v72, v73 offset0:9 offset1:73
    s_mov_b64 exec, -1
    s_waitcnt lgkmcnt(7)
    v_cmp_gt_u32 vcc, s46, v225
    v_lshl_add_u32 v225, v89, 9, v225
    v_lshlrev_b32 v233, 2, v225
    s_and_b64 exec, vcc, s[66:67]
    ds_write2st64_b32 v233, v74, v75 offset0:9 offset1:73
    s_mov_b64 exec, -1
    s_waitcnt lgkmcnt(7)
    v_cmp_gt_u32 vcc, s46, v226
    v_lshl_add_u32 v226, v90, 9, v226
    v_lshlrev_b32 v234, 2, v226
    s_and_b64 exec, vcc, s[68:69]
    ds_write2st64_b32 v234, v76, v77 offset0:9 offset1:73
    s_mov_b64 exec, -1
    s_waitcnt lgkmcnt(7)
    v_cmp_gt_u32 vcc, s46, v227
    v_lshl_add_u32 v227, v91, 9, v227
    v_lshlrev_b32 v235, 2, v227
    s_and_b64 exec, vcc, s[70:71]
    ds_write2st64_b32 v235, v78, v79 offset0:9 offset1:73
    s_mov_b64 exec, -1
    s_waitcnt lgkmcnt(7)
    v_cmp_gt_u32 vcc, s46, v228
    v_lshl_add_u32 v228, v92, 9, v228
    v_lshlrev_b32 v236, 2, v228
    s_and_b64 exec, vcc, s[72:73]
    ds_write2st64_b32 v236, v80, v81 offset0:9 offset1:73
    s_mov_b64 exec, -1
    s_add_u32 m0, s57, 0
    s_nop 0
    buffer_load_dwordx4 v124, s[28:31], 0 offen  lds
    s_add_u32 m0, s57, 8192
    s_nop 0
    buffer_load_dwordx4 v125, s[28:31], 0 offen  lds
    s_add_u32 m0, s57, 16384
    s_nop 0
    buffer_load_dwordx4 v126, s[28:31], 0 offen  lds
    s_add_u32 m0, s57, 24576
    s_nop 0
    buffer_load_dwordx4 v127, s[28:31], 0 offen  lds
    s_add_u32 m0, s57, 32768
    s_nop 0
    buffer_load_dwordx4 v32, s[28:31], 0 offen  lds
    v_and_b32 v40, 7, v1
    v_lshlrev_b32 v40, 2, v40
    v_lshrrev_b32 v52, 3, v1
    v_lshlrev_b32 v52, 2, v52
    s_waitcnt lgkmcnt(0)
    s_barrier
    ds_read_b32 v41, v40 offset:0
    ds_read_b32 v53, v52 offset:0
    s_waitcnt lgkmcnt(0)
    s_cmp_eq_u32 s52, 0
    s_cbranch_scc1 K2_NOSEL
    v_lshl_add_u32 v53, v53, 5, v52
    v_lshl_add_u32 v54, v41, 5, v40
    v_cmp_gt_u32 vcc, v54, v53
    s_sub_u32 s47, 11, s12
    s_cmp_lt_u32 s12, 4
    s_cselect_b32 s47, s12, s47
    s_mov_b32 s58, 0
    s_bfe_u32 s48, vcc_lo, 0x80008
    s_bcnt1_i32_b32 s48, s48
    s_cmp_eq_u32 s48, s47
    s_cselect_b32 s58, 1, s58
    s_bfe_u32 s48, vcc_lo, 0x80010
    s_bcnt1_i32_b32 s48, s48
    s_cmp_eq_u32 s48, s47
    s_cselect_b32 s58, 2, s58
    s_bfe_u32 s48, vcc_lo, 0x80018
    s_bcnt1_i32_b32 s48, s48
    s_cmp_eq_u32 s48, s47
    s_cselect_b32 s58, 3, s58
    s_bfe_u32 s48, vcc_hi, 0x80000
    s_bcnt1_i32_b32 s48, s48
    s_cmp_eq_u32 s48, s47
    s_cselect_b32 s58, 4, s58
    s_bfe_u32 s48, vcc_hi, 0x80008
    s_bcnt1_i32_b32 s48, s48
    s_cmp_eq_u32 s48, s47
    s_cselect_b32 s58, 5, s58
    s_bfe_u32 s48, vcc_hi, 0x80010
    s_bcnt1_i32_b32 s48, s48
    s_cmp_eq_u32 s48, s47
    s_cselect_b32 s58, 6, s58
    s_bfe_u32 s48, vcc_hi, 0x80018
    s_bcnt1_i32_b32 s48, s48
    s_cmp_eq_u32 s48, s47
    s_cselect_b32 s58, 7, s58
    s_mul_i32 s14, s3, 200
    s_mul_i32 s15, s58, 25
    s_add_u32 s14, s14, s15
    s_lshl_b32 s14, s14, 7
    s_lshl_b32 s15, s15, 7
    s_add_u32 s15, s15, 71936
    v_lshl_add_u32 v53, v35, 7, v71
    v_add_u32 v53, s15, v53
    ds_read_b128 v[72:75], v53 offset:0
    ds_read_b128 v[76:79], v53 offset:32
    ds_read_b128 v[80:83], v53 offset:64
    ds_read_b128 v[84:87], v53 offset:96
    s_mov_b32 s56, 1
K2_NOSEL:
    s_lshl_b32 s47, s58, 9
    v_add_u32 v40, s47, v52
    v_lshlrev_b32 v9, 2, v40
    v_and_b32 v40, 7, v1
    v_bfe_u32 v53, v1, 3, 2
    v_lshl_add_u32 v40, v40, 2, v53
    v_add_u32 v11, s47, v40
    v_lshlrev_b32 v10, 2, v11
    v_bfe_u32 v53, v1, 2, 2
    v_lshl_add_u32 v40, v36, 2, v53
    v_lshlrev_b32 v40, 2, v40
    v_add_lshl_u32 v12, s47, v40, 2
    v_cmp_lt_u32 vcc, s46, v41
    v_readlane_b32 s55, v41, s58
    ds_read_b128 v[88:91], v9 offset:2304
    ds_read_b32 v20, v10 offset:18688
    ds_read_b128 v[48:51], v9 offset:2432
    ds_read_b32 v44, v10 offset:18816
    ds_read_u8 v21, v10 offset:2306
    s_add_u32 s55, s55, 31
    s_lshr_b32 s55, s55, 5
    s_mov_b64 s[48:49], vcc
    s_waitcnt lgkmcnt(0)
    v_mad_u32_u16 v28, v88, s60, v2
    v_mad_u32_u16 v29, v89, s60, v3
    v_mad_u32_u16 v30, v90, s60, v4
    v_mad_u32_u16 v31, v91, s60, v13
    s_add_u32 m0, s44, 0
    s_nop 0
    buffer_load_dwordx4 v28, s[24:27], 0 offen offset:0 lds
    buffer_load_dwordx4 v29, s[24:27], 0 offen offset:1024 lds
    buffer_load_dwordx4 v30, s[24:27], 0 offen offset:2048 lds
    buffer_load_dwordx4 v31, s[24:27], 0 offen offset:3072 lds
    v_add_u32 v68, v20, v71
    v_cmp_gt_i32 s[64:65], 0, v20
    buffer_load_dwordx4 v[112:115], v68, s[36:39], 0 offen nt
    v_mov_b32 v88, v48
    v_mov_b32 v89, v49
    v_mov_b32 v90, v50
    v_mov_b32 v91, v51
    v_mov_b32 v20, v44
    v_mad_u32_u16 v28, v88, s60, v2
    v_mad_u32_u16 v29, v89, s60, v3
    v_mad_u32_u16 v30, v90, s60, v4
    v_mad_u32_u16 v31, v91, s60, v13
    v_add_u32 v69, v20, v71
    v_cmp_gt_i32 s[66:67], 0, v20
    v_add_u32 v21, v21, v14
    ds_read2_b64 v[116:119], v21 offset0:0 offset1:66
    ds_read2_b64 v[120:123], v21 offset0:132 offset1:198
    ds_read_b128 v[88:91], v9 offset:2560
    s_cmp_eq_u32 s52, 0
    s_cbranch_scc1 K2_NOQ
    s_mov_b32 s52, 0
    v_mfma_f32_32x32x16_bf16 v[224:239], v[72:75], v[192:195], 0
    v_mfma_f32_32x32x16_bf16 v[224:239], v[76:79], v[200:203], v[224:239]
    v_mfma_f32_32x32x16_bf16 v[224:239], v[80:83], v[208:211], v[224:239]
    v_mfma_f32_32x32x16_bf16 v[224:239], v[84:87], v[216:219], v[224:239]
    v_mfma_f32_32x32x16_bf16 v[240:255], v[72:75], v[196:199], 0
    v_mfma_f32_32x32x16_bf16 v[240:255], v[76:79], v[204:207], v[240:255]
    v_mfma_f32_32x32x16_bf16 v[240:255], v[80:83], v[212:215], v[240:255]
    v_mfma_f32_32x32x16_bf16 v[240:255], v[84:87], v[220:223], v[240:255]
    s_mov_b32 s46, 0xbfb8aa3b
    s_nop 11
    v_mul_f32 v224, s46, v224
    v_mul_f32 v225, s46, v225
    v_mul_f32 v226, s46, v226
    v_mul_f32 v227, s46, v227
    v_mul_f32 v228, s46, v228
    v_mul_f32 v229, s46, v229
    v_mul_f32 v230, s46, v230
    v_mul_f32 v231, s46, v231
    v_mul_f32 v232, s46, v232
    v_mul_f32 v233, s46, v233
    v_mul_f32 v234, s46, v234
    v_mul_f32 v235, s46, v235
    v_mul_f32 v236, s46, v236
    v_mul_f32 v237, s46, v237
    v_mul_f32 v238, s46, v238
    v_mul_f32 v239, s46, v239
    v_cvt_pk_bf16_f32 v176, v224, v225
    v_cvt_pk_bf16_f32 v177, v226, v227
    v_cvt_pk_bf16_f32 v178, v228, v229
    v_cvt_pk_bf16_f32 v179, v230, v231
    v_cvt_pk_bf16_f32 v184, v232, v233
    v_cvt_pk_bf16_f32 v185, v234, v235
    v_cvt_pk_bf16_f32 v186, v236, v237
    v_cvt_pk_bf16_f32 v187, v238, v239
    v_mul_f32 v240, s46, v240
    v_mul_f32 v241, s46, v241
    v_mul_f32 v242, s46, v242
    v_mul_f32 v243, s46, v243
    v_mul_f32 v244, s46, v244
    v_mul_f32 v245, s46, v245
    v_mul_f32 v246, s46, v246
    v_mul_f32 v247, s46, v247
    v_mul_f32 v248, s46, v248
    v_mul_f32 v249, s46, v249
    v_mul_f32 v250, s46, v250
    v_mul_f32 v251, s46, v251
    v_mul_f32 v252, s46, v252
    v_mul_f32 v253, s46, v253
    v_mul_f32 v254, s46, v254
    v_mul_f32 v255, s46, v255
    v_cvt_pk_bf16_f32 v180, v240, v241
    v_cvt_pk_bf16_f32 v181, v242, v243
    v_cvt_pk_bf16_f32 v182, v244, v245
    v_cvt_pk_bf16_f32 v183, v246, v247
    v_cvt_pk_bf16_f32 v188, v248, v249
    v_cvt_pk_bf16_f32 v189, v250, v251
    v_cvt_pk_bf16_f32 v190, v252, v253
    v_cvt_pk_bf16_f32 v191, v254, v255
    v_mov_b32 v192, 0
    v_mov_b32 v193, 0
    v_mov_b32 v194, 0
    v_mov_b32 v195, 0
    v_mov_b32 v196, 0
    v_mov_b32 v197, 0
    v_mov_b32 v198, 0
    v_mov_b32 v199, 0
    v_mov_b32 v200, 0
    v_mov_b32 v201, 0
    v_mov_b32 v202, 0
    v_mov_b32 v203, 0
    v_mov_b32 v204, 0
    v_mov_b32 v205, 0
    v_mov_b32 v206, 0
    v_mov_b32 v207, 0
    v_mov_b32 v208, 0
    v_mov_b32 v209, 0
    v_mov_b32 v210, 0
    v_mov_b32 v211, 0
    v_mov_b32 v212, 0
    v_mov_b32 v213, 0
    v_mov_b32 v214, 0
    v_mov_b32 v215, 0
    v_mov_b32 v216, 0
    v_mov_b32 v217, 0
    v_mov_b32 v218, 0
    v_mov_b32 v219, 0
    v_mov_b32 v220, 0
    v_mov_b32 v221, 0
    v_mov_b32 v222, 0
    v_mov_b32 v223, 0
K2_NOQ:
    s_waitcnt vmcnt(4)
    s_barrier
    s_cmp_lg_u64 s[48:49], 0
    s_cbranch_scc1 K2_OVF
    s_add_u32 s50, s50, s51
    s_add_u32 s59, s59, s61
    s_cmp_lt_u32 s50, s53
    s_cselect_b32 s45, 1, 0
    s_cmp_lt_u32 s59, s62
    s_cselect_b32 s45, 1, s45
    s_cmp_eq_u32 s55, 0
    s_cbranch_scc1 K2_LOOPEND
    s_waitcnt vmcnt(0)
    ds_read_b128 v[96:99], v5 offset:0
    ds_read_b128 v[100:103], v6 offset:0
    ds_read_b128 v[104:107], v7 offset:0
    ds_read_b128 v[108:111], v8 offset:0
    v_xor_b32 v70, 0x80000000, v68
    s_mov_b64 exec, s[64:65]
    ds_read_b128 v[112:115], v70
    s_mov_b64 exec, -1
    s_add_u32 m0, s44, 32768
    s_nop 0
    buffer_load_dwordx4 v28, s[24:27], 0 offen offset:0 lds
    buffer_load_dwordx4 v29, s[24:27], 0 offen offset:1024 lds
    buffer_load_dwordx4 v30, s[24:27], 0 offen offset:2048 lds
    buffer_load_dwordx4 v31, s[24:27], 0 offen offset:3072 lds
    buffer_load_dwordx4 v[64:67], v69, s[36:39], 0 offen nt
    v_mov_b32 v60, 0
    v_mov_b32 v244, 0
    v_mov_b32 v61, 0
    v_mov_b32 v245, 0
    v_mov_b32 v62, 0
    v_mov_b32 v246, 0
    v_mov_b32 v63, 0
    v_mov_b32 v247, 0
    s_waitcnt lgkmcnt(0)
    v_mfma_f32_32x32x16_bf16 v[224:239], v[96:99], v[128:131], 0
    v_mfma_f32_32x32x16_bf16 v[224:239], v[100:103], v[136:139], v[224:239]
    v_mfma_f32_32x32x16_bf16 v[224:239], v[104:107], v[144:147], v[224:239]
    v_mfma_f32_32x32x16_bf16 v[224:239], v[108:111], v[152:155], v[224:239]
    v_mfma_f32_32x32x16_bf16 v[224:239], v[116:119], v[176:179], v[224:239]
    v_mfma_f32_32x32x16_bf16 v[224:239], v[120:123], v[184:187], v[224:239]
    v_mfma_f32_32x32x16_bf16 v[224:239], v[112:115], v[160:163], v[224:239]
    v_mad_u32_u16 v28, v88, s60, v2
    v_mad_u32_u16 v29, v89, s60, v3
    v_mad_u32_u16 v30, v90, s60, v4
    v_mad_u32_u16 v31, v91, s60, v13
    s_add_u32 m0, s44, 0
    s_nop 0
    buffer_load_dwordx4 v28, s[24:27], 0 offen offset:0 lds
    buffer_load_dwordx4 v29, s[24:27], 0 offen offset:1024 lds
    buffer_load_dwordx4 v30, s[24:27], 0 offen offset:2048 lds
    buffer_load_dwordx4 v31, s[24:27], 0 offen offset:3072 lds
    s_nop 7
K2_LOOP:
    ds_read_b128 v[92:95], v12 offset:2304
    ds_read_b128 v[88:91], v9 offset:2688
    ds_read_b32 v20, v10 offset:18944
    ds_read_u8 v21, v10 offset:2434
    s_setprio 1
    v_exp_f32 v40, v224
    v_mfma_f32_32x32x16_bf16 v[208:223], v[244:247], v[60:63], v[208:223]
    v_exp_f32 v41, v225
    v_exp_f32 v42, v226
    v_exp_f32 v43, v227
    v_mfma_f32_32x32x16_bf16 v[240:255], v[96:99], v[132:135], 0
    v_exp_f32 v44, v228
    v_exp_f32 v45, v229
    v_exp_f32 v46, v230
    v_mfma_f32_32x32x16_bf16 v[240:255], v[100:103], v[140:143], v[240:255]
    v_exp_f32 v47, v231
    v_exp_f32 v48, v232
    v_exp_f32 v49, v233
    v_mfma_f32_32x32x16_bf16 v[240:255], v[104:107], v[148:151], v[240:255]
    v_exp_f32 v50, v234
    v_exp_f32 v51, v235
    v_exp_f32 v52, v236
    v_mfma_f32_32x32x16_bf16 v[240:255], v[108:111], v[156:159], v[240:255]
    v_exp_f32 v53, v237
    s_waitcnt lgkmcnt(0)
    v_add_u32_sdwa v24, v92, v15 dst_sel:DWORD dst_unused:UNUSED_PAD src0_sel:BYTE_2 src1_sel:DWORD
    v_add_u32_sdwa v25, v93, v15 dst_sel:DWORD dst_unused:UNUSED_PAD src0_sel:BYTE_2 src1_sel:DWORD
    v_add_u32_sdwa v26, v94, v15 dst_sel:DWORD dst_unused:UNUSED_PAD src0_sel:BYTE_2 src1_sel:DWORD
    v_add_u32_sdwa v27, v95, v15 dst_sel:DWORD dst_unused:UNUSED_PAD src0_sel:BYTE_2 src1_sel:DWORD
    v_exp_f32 v54, v238
    v_exp_f32 v55, v239
    s_waitcnt vmcnt(4)
    ds_read_b128 v[96:99], v5 offset:32768
    v_pk_add_f32 v[40:41], v[40:41], 1.0 op_sel_hi:[1,0]
    ds_read_b128 v[100:103], v6 offset:32768
    v_pk_add_f32 v[42:43], v[42:43], 1.0 op_sel_hi:[1,0]
    ds_read_b128 v[104:107], v7 offset:32768
    v_pk_add_f32 v[44:45], v[44:45], 1.0 op_sel_hi:[1,0]
    ds_read_b128 v[108:111], v8 offset:32768
    v_pk_add_f32 v[46:47], v[46:47], 1.0 op_sel_hi:[1,0]
    ds_read_b64_tr_b16 v[56:57], v24
    v_pk_add_f32 v[48:49], v[48:49], 1.0 op_sel_hi:[1,0]
    ds_read_b64_tr_b16 v[58:59], v25
    v_pk_add_f32 v[50:51], v[50:51], 1.0 op_sel_hi:[1,0]
    ds_read_b64_tr_b16 v[60:61], v26
    v_pk_add_f32 v[52:53], v[52:53], 1.0 op_sel_hi:[1,0]
    ds_read_b64_tr_b16 v[62:63], v27
    v_pk_add_f32 v[54:55], v[54:55], 1.0 op_sel_hi:[1,0]
    v_mfma_f32_32x32x16_bf16 v[240:255], v[116:119], v[180:183], v[240:255]
    v_rcp_f32 v40, v40
    v_rcp_f32 v41, v41
    v_rcp_f32 v42, v42
    v_mfma_f32_32x32x16_bf16 v[240:255], v[120:123], v[188:191], v[240:255]
    v_rcp_f32 v43, v43
    v_rcp_f32 v44, v44
    v_rcp_f32 v45, v45
    v_mfma_f32_32x32x16_bf16 v[240:255], v[112:115], v[164:167], v[240:255]
    v_rcp_f32 v46, v46
    v_rcp_f32 v47, v47
    v_rcp_f32 v48, v48
    v_rcp_f32 v49, v49
    v_rcp_f32 v50, v50
    v_add_u32 v68, v20, v71
    v_cmp_gt_i32 s[64:65], 0, v20
    v_add_u32 v21, v21, v14
    v_mad_u32_u16 v28, v88, s60, v2
    v_mad_u32_u16 v29, v89, s60, v3
    v_mad_u32_u16 v30, v90, s60, v4
    v_mad_u32_u16 v31, v91, s60, v13
    v_rcp_f32 v51, v51
    buffer_load_dwordx4 v[112:115], v68, s[36:39], 0 offen nt
    v_rcp_f32 v52, v52
    s_waitcnt lgkmcnt(0)
    ds_read2_b64 v[116:119], v21 offset0:0 offset1:66
    ds_read2_b64 v[120:123], v21 offset0:132 offset1:198
    v_rcp_f32 v53, v53
    v_rcp_f32 v54, v54
    v_rcp_f32 v55, v55
    v_pk_mul_f32 v[40:41], v[224:225], v[40:41]
    v_pk_mul_f32 v[42:43], v[226:227], v[42:43]
    s_add_u32 m0, s44, 32768
    v_pk_mul_f32 v[44:45], v[228:229], v[44:45]
    v_pk_mul_f32 v[46:47], v[230:231], v[46:47]
    buffer_load_dwordx4 v28, s[24:27], 0 offen offset:0 lds
    v_pk_mul_f32 v[48:49], v[232:233], v[48:49]
    v_pk_mul_f32 v[50:51], v[234:235], v[50:51]
    v_pk_mul_f32 v[52:53], v[236:237], v[52:53]
    v_pk_mul_f32 v[54:55], v[238:239], v[54:55]
    v_cvt_pk_bf16_f32 v224, v40, v41
    v_cvt_pk_bf16_f32 v225, v42, v43
    v_cvt_pk_bf16_f32 v226, v44, v45
    v_cvt_pk_bf16_f32 v227, v46, v47
    v_cvt_pk_bf16_f32 v228, v48, v49
    v_cvt_pk_bf16_f32 v229, v50, v51
    v_mfma_f32_32x32x16_bf16 v[192:207], v[224:227], v[56:59], v[192:207]
    v_cvt_pk_bf16_f32 v230, v52, v53
    v_cvt_pk_bf16_f32 v231, v54, v55
    s_sub_u32 s55, s55, 1
    s_cmp_eq_u32 s55, 0
    s_cbranch_scc1 K2_LAST
    v_exp_f32 v40, v240
    v_exp_f32 v41, v241
    v_mfma_f32_32x32x16_bf16 v[192:207], v[228:231], v[60:63], v[192:207]
    v_exp_f32 v42, v242
    v_exp_f32 v43, v243
    v_exp_f32 v44, v244
    v_mfma_f32_32x32x16_bf16 v[224:239], v[96:99], v[128:131], 0
    v_exp_f32 v45, v245
    buffer_load_dwordx4 v29, s[24:27], 0 offen offset:1024 lds
    v_exp_f32 v46, v246
    v_exp_f32 v47, v247
    v_mfma_f32_32x32x16_bf16 v[224:239], v[100:103], v[136:139], v[224:239]
    v_exp_f32 v48, v248
    v_exp_f32 v49, v249
    v_exp_f32 v50, v250
    v_mfma_f32_32x32x16_bf16 v[224:239], v[104:107], v[144:147], v[224:239]
    v_exp_f32 v51, v251
    v_exp_f32 v52, v252
    v_exp_f32 v53, v253
    v_xor_b32 v70, 0x80000000, v69
    s_mov_b64 exec, s[66:67]
    ds_read_b128 v[64:67], v70
    s_mov_b64 exec, -1
    v_exp_f32 v54, v254
    v_exp_f32 v55, v255
    v_pk_add_f32 v[40:41], v[40:41], 1.0 op_sel_hi:[1,0]
    v_pk_add_f32 v[42:43], v[42:43], 1.0 op_sel_hi:[1,0]
    v_pk_add_f32 v[44:45], v[44:45], 1.0 op_sel_hi:[1,0]
    v_pk_add_f32 v[46:47], v[46:47], 1.0 op_sel_hi:[1,0]
    v_pk_add_f32 v[48:49], v[48:49], 1.0 op_sel_hi:[1,0]
    v_pk_add_f32 v[50:51], v[50:51], 1.0 op_sel_hi:[1,0]
    v_pk_add_f32 v[52:53], v[52:53], 1.0 op_sel_hi:[1,0]
    v_pk_add_f32 v[54:55], v[54:55], 1.0 op_sel_hi:[1,0]
    v_mfma_f32_32x32x16_bf16 v[224:239], v[108:111], v[152:155], v[224:239]
    v_rcp_f32 v40, v40
    v_rcp_f32 v41, v41
    buffer_load_dwordx4 v30, s[24:27], 0 offen offset:2048 lds
    v_rcp_f32 v42, v42
    s_waitcnt lgkmcnt(0)
    v_mfma_f32_32x32x16_bf16 v[224:239], v[116:119], v[176:179], v[224:239]
    v_rcp_f32 v43, v43
    v_rcp_f32 v44, v44
    v_rcp_f32 v45, v45
    v_mfma_f32_32x32x16_bf16 v[224:239], v[120:123], v[184:187], v[224:239]
    s_setprio 0
    v_rcp_f32 v46, v46
    v_rcp_f32 v47, v47
    v_rcp_f32 v48, v48
    v_mfma_f32_32x32x16_bf16 v[224:239], v[64:67], v[160:163], v[224:239]
    v_rcp_f32 v49, v49
    v_rcp_f32 v50, v50
    v_rcp_f32 v51, v51
    v_rcp_f32 v52, v52
    v_rcp_f32 v53, v53
    v_rcp_f32 v54, v54
    v_rcp_f32 v55, v55
    v_pk_mul_f32 v[40:41], v[240:241], v[40:41]
    v_pk_mul_f32 v[42:43], v[242:243], v[42:43]
    v_pk_mul_f32 v[44:45], v[244:245], v[44:45]
    v_pk_mul_f32 v[46:47], v[246:247], v[46:47]
    buffer_load_dwordx4 v31, s[24:27], 0 offen offset:3072 lds
    v_pk_mul_f32 v[48:49], v[248:249], v[48:49]
    v_pk_mul_f32 v[50:51], v[250:251], v[50:51]
    v_pk_mul_f32 v[52:53], v[252:253], v[52:53]
    v_pk_mul_f32 v[54:55], v[254:255], v[54:55]
    v_cvt_pk_bf16_f32 v240, v40, v41
    v_cvt_pk_bf16_f32 v241, v42, v43
    v_cvt_pk_bf16_f32 v242, v44, v45
    v_cvt_pk_bf16_f32 v243, v46, v47
    v_cvt_pk_bf16_f32 v244, v48, v49
    v_cvt_pk_bf16_f32 v245, v50, v51
    v_mfma_f32_32x32x16_bf16 v[208:223], v[240:243], v[56:59], v[208:223]
    v_cvt_pk_bf16_f32 v246, v52, v53
    v_cvt_pk_bf16_f32 v247, v54, v55
K2_LOOP1:
    ds_read_b128 v[92:95], v12 offset:2432
    ds_read_b128 v[88:91], v9 offset:2816
    ds_read_b32 v20, v10 offset:19072
    ds_read_u8 v21, v10 offset:2562
    s_setprio 1
    v_exp_f32 v40, v224
    v_mfma_f32_32x32x16_bf16 v[208:223], v[244:247], v[60:63], v[208:223]
    v_exp_f32 v41, v225
    v_exp_f32 v42, v226
    v_exp_f32 v43, v227
    v_mfma_f32_32x32x16_bf16 v[240:255], v[96:99], v[132:135], 0
    v_exp_f32 v44, v228
    v_exp_f32 v45, v229
    v_exp_f32 v46, v230
    v_mfma_f32_32x32x16_bf16 v[240:255], v[100:103], v[140:143], v[240:255]
    v_exp_f32 v47, v231
    v_exp_f32 v48, v232
    v_exp_f32 v49, v233
    v_mfma_f32_32x32x16_bf16 v[240:255], v[104:107], v[148:151], v[240:255]
    v_exp_f32 v50, v234
    v_exp_f32 v51, v235
    v_exp_f32 v52, v236
    v_mfma_f32_32x32x16_bf16 v[240:255], v[108:111], v[156:159], v[240:255]
    v_exp_f32 v53, v237
    s_waitcnt lgkmcnt(0)
    v_add_u32_sdwa v24, v92, v15 dst_sel:DWORD dst_unused:UNUSED_PAD src0_sel:BYTE_2 src1_sel:DWORD
    v_add_u32_sdwa v25, v93, v15 dst_sel:DWORD dst_unused:UNUSED_PAD src0_sel:BYTE_2 src1_sel:DWORD
    v_add_u32_sdwa v26, v94, v15 dst_sel:DWORD dst_unused:UNUSED_PAD src0_sel:BYTE_2 src1_sel:DWORD
    v_add_u32_sdwa v27, v95, v15 dst_sel:DWORD dst_unused:UNUSED_PAD src0_sel:BYTE_2 src1_sel:DWORD
    v_exp_f32 v54, v238
    v_exp_f32 v55, v239
    s_waitcnt vmcnt(4)
    ds_read_b128 v[96:99], v5 offset:0
    v_pk_add_f32 v[40:41], v[40:41], 1.0 op_sel_hi:[1,0]
    ds_read_b128 v[100:103], v6 offset:0
    v_pk_add_f32 v[42:43], v[42:43], 1.0 op_sel_hi:[1,0]
    ds_read_b128 v[104:107], v7 offset:0
    v_pk_add_f32 v[44:45], v[44:45], 1.0 op_sel_hi:[1,0]
    ds_read_b128 v[108:111], v8 offset:0
    v_pk_add_f32 v[46:47], v[46:47], 1.0 op_sel_hi:[1,0]
    ds_read_b64_tr_b16 v[56:57], v24
    v_pk_add_f32 v[48:49], v[48:49], 1.0 op_sel_hi:[1,0]
    ds_read_b64_tr_b16 v[58:59], v25
    v_pk_add_f32 v[50:51], v[50:51], 1.0 op_sel_hi:[1,0]
    ds_read_b64_tr_b16 v[60:61], v26
    v_pk_add_f32 v[52:53], v[52:53], 1.0 op_sel_hi:[1,0]
    ds_read_b64_tr_b16 v[62:63], v27
    v_pk_add_f32 v[54:55], v[54:55], 1.0 op_sel_hi:[1,0]
    v_mfma_f32_32x32x16_bf16 v[240:255], v[116:119], v[180:183], v[240:255]
    v_rcp_f32 v40, v40
    v_rcp_f32 v41, v41
    v_rcp_f32 v42, v42
    v_mfma_f32_32x32x16_bf16 v[240:255], v[120:123], v[188:191], v[240:255]
    v_rcp_f32 v43, v43
    v_rcp_f32 v44, v44
    v_rcp_f32 v45, v45
    v_mfma_f32_32x32x16_bf16 v[240:255], v[64:67], v[164:167], v[240:255]
    v_rcp_f32 v46, v46
    v_rcp_f32 v47, v47
    v_rcp_f32 v48, v48
    v_rcp_f32 v49, v49
    v_rcp_f32 v50, v50
    v_add_u32 v69, v20, v71
    v_cmp_gt_i32 s[66:67], 0, v20
    v_add_u32 v21, v21, v14
    v_mad_u32_u16 v28, v88, s60, v2
    v_mad_u32_u16 v29, v89, s60, v3
    v_mad_u32_u16 v30, v90, s60, v4
    v_mad_u32_u16 v31, v91, s60, v13
    v_rcp_f32 v51, v51
    buffer_load_dwordx4 v[64:67], v69, s[36:39], 0 offen nt
    v_rcp_f32 v52, v52
    s_waitcnt lgkmcnt(0)
    ds_read2_b64 v[116:119], v21 offset0:0 offset1:66
    ds_read2_b64 v[120:123], v21 offset0:132 offset1:198
    v_rcp_f32 v53, v53
    v_rcp_f32 v54, v54
    v_rcp_f32 v55, v55
    v_pk_mul_f32 v[40:41], v[224:225], v[40:41]
    v_pk_mul_f32 v[42:43], v[226:227], v[42:43]
    s_add_u32 m0, s44, 0
    v_pk_mul_f32 v[44:45], v[228:229], v[44:45]
    v_pk_mul_f32 v[46:47], v[230:231], v[46:47]
    buffer_load_dwordx4 v28, s[24:27], 0 offen offset:0 lds
    v_pk_mul_f32 v[48:49], v[232:233], v[48:49]
    v_pk_mul_f32 v[50:51], v[234:235], v[50:51]
    v_pk_mul_f32 v[52:53], v[236:237], v[52:53]
    v_pk_mul_f32 v[54:55], v[238:239], v[54:55]
    v_cvt_pk_bf16_f32 v224, v40, v41
    v_cvt_pk_bf16_f32 v225, v42, v43
    v_cvt_pk_bf16_f32 v226, v44, v45
    v_cvt_pk_bf16_f32 v227, v46, v47
    v_cvt_pk_bf16_f32 v228, v48, v49
    v_cvt_pk_bf16_f32 v229, v50, v51
    v_mfma_f32_32x32x16_bf16 v[192:207], v[224:227], v[56:59], v[192:207]
    v_cvt_pk_bf16_f32 v230, v52, v53
    v_cvt_pk_bf16_f32 v231, v54, v55
    s_sub_u32 s55, s55, 1
    s_cmp_eq_u32 s55, 0
    s_cbranch_scc1 K2_LAST
    v_exp_f32 v40, v240
    v_exp_f32 v41, v241
    v_mfma_f32_32x32x16_bf16 v[192:207], v[228:231], v[60:63], v[192:207]
    v_exp_f32 v42, v242
    v_exp_f32 v43, v243
    v_exp_f32 v44, v244
    v_mfma_f32_32x32x16_bf16 v[224:239], v[96:99], v[128:131], 0
    v_exp_f32 v45, v245
    buffer_load_dwordx4 v29, s[24:27], 0 offen offset:1024 lds
    v_exp_f32 v46, v246
    v_exp_f32 v47, v247
    v_mfma_f32_32x32x16_bf16 v[224:239], v[100:103], v[136:139], v[224:239]
    v_exp_f32 v48, v248
    v_exp_f32 v49, v249
    v_exp_f32 v50, v250
    v_mfma_f32_32x32x16_bf16 v[224:239], v[104:107], v[144:147], v[224:239]
    v_exp_f32 v51, v251
    v_exp_f32 v52, v252
    v_add_u32 v9, 256, v9
    v_add_u32 v10, 256, v10
    v_add_u32 v12, 256, v12
    v_exp_f32 v53, v253
    v_xor_b32 v70, 0x80000000, v68
    s_mov_b64 exec, s[64:65]
    ds_read_b128 v[112:115], v70
    s_mov_b64 exec, -1
    v_exp_f32 v54, v254
    v_exp_f32 v55, v255
    v_pk_add_f32 v[40:41], v[40:41], 1.0 op_sel_hi:[1,0]
    v_pk_add_f32 v[42:43], v[42:43], 1.0 op_sel_hi:[1,0]
    v_pk_add_f32 v[44:45], v[44:45], 1.0 op_sel_hi:[1,0]
    v_pk_add_f32 v[46:47], v[46:47], 1.0 op_sel_hi:[1,0]
    v_pk_add_f32 v[48:49], v[48:49], 1.0 op_sel_hi:[1,0]
    v_pk_add_f32 v[50:51], v[50:51], 1.0 op_sel_hi:[1,0]
    v_pk_add_f32 v[52:53], v[52:53], 1.0 op_sel_hi:[1,0]
    v_pk_add_f32 v[54:55], v[54:55], 1.0 op_sel_hi:[1,0]
    v_mfma_f32_32x32x16_bf16 v[224:239], v[108:111], v[152:155], v[224:239]
    v_rcp_f32 v40, v40
    v_rcp_f32 v41, v41
    buffer_load_dwordx4 v30, s[24:27], 0 offen offset:2048 lds
    v_rcp_f32 v42, v42
    s_waitcnt lgkmcnt(0)
    v_mfma_f32_32x32x16_bf16 v[224:239], v[116:119], v[176:179], v[224:239]
    v_rcp_f32 v43, v43
    v_rcp_f32 v44, v44
    v_rcp_f32 v45, v45
    v_mfma_f32_32x32x16_bf16 v[224:239], v[120:123], v[184:187], v[224:239]
    s_setprio 0
    v_rcp_f32 v46, v46
    v_rcp_f32 v47, v47
    v_rcp_f32 v48, v48
    v_mfma_f32_32x32x16_bf16 v[224:239], v[112:115], v[160:163], v[224:239]
    v_rcp_f32 v49, v49
    v_rcp_f32 v50, v50
    v_rcp_f32 v51, v51
    v_rcp_f32 v52, v52
    v_rcp_f32 v53, v53
    v_rcp_f32 v54, v54
    v_rcp_f32 v55, v55
    v_pk_mul_f32 v[40:41], v[240:241], v[40:41]
    v_pk_mul_f32 v[42:43], v[242:243], v[42:43]
    v_pk_mul_f32 v[44:45], v[244:245], v[44:45]
    v_pk_mul_f32 v[46:47], v[246:247], v[46:47]
    buffer_load_dwordx4 v31, s[24:27], 0 offen offset:3072 lds
    v_pk_mul_f32 v[48:49], v[248:249], v[48:49]
    v_pk_mul_f32 v[50:51], v[250:251], v[50:51]
    v_pk_mul_f32 v[52:53], v[252:253], v[52:53]
    v_pk_mul_f32 v[54:55], v[254:255], v[54:55]
    v_cvt_pk_bf16_f32 v240, v40, v41
    v_cvt_pk_bf16_f32 v241, v42, v43
    v_cvt_pk_bf16_f32 v242, v44, v45
    v_cvt_pk_bf16_f32 v243, v46, v47
    v_cvt_pk_bf16_f32 v244, v48, v49
    v_cvt_pk_bf16_f32 v245, v50, v51
    v_mfma_f32_32x32x16_bf16 v[208:223], v[240:243], v[56:59], v[208:223]
    v_cvt_pk_bf16_f32 v246, v52, v53
    v_cvt_pk_bf16_f32 v247, v54, v55
    s_branch K2_LOOP
K2_LAST:
    v_exp_f32 v40, v240
    v_exp_f32 v41, v241
    v_mfma_f32_32x32x16_bf16 v[192:207], v[228:231], v[60:63], v[192:207]
    v_exp_f32 v42, v242
    v_exp_f32 v43, v243
    s_waitcnt lgkmcnt(0)
    s_cmp_lg_u32 s45, 0
    s_cbranch_scc1 K2_NOEL
    v_add_u32 v70, 141568, v38
    ds_read_b128 v[128:131], v70 offset:0
    ds_read_b128 v[132:135], v70 offset:1024
    ds_read_b128 v[136:139], v70 offset:2048
    ds_read_b128 v[140:143], v70 offset:3072
    ds_read_b128 v[144:147], v70 offset:4096
    ds_read_b128 v[148:151], v70 offset:5120
    ds_read_b128 v[152:155], v70 offset:6144
    ds_read_b128 v[156:159], v70 offset:7168
    ds_read_b128 v[160:163], v70 offset:8192
    ds_read_b128 v[164:167], v70 offset:9216
    ds_read_b128 v[168:171], v70 offset:10240
    ds_read_b128 v[172:175], v70 offset:11264
    ds_read_b128 v[176:179], v70 offset:12288
    ds_read_b128 v[180:183], v70 offset:13312
    ds_read_b128 v[184:187], v70 offset:14336
    ds_read_b128 v[188:191], v70 offset:15360
    s_cmp_eq_u32 s56, 1
    s_cbranch_scc1 K2_XV1
    buffer_load_dwordx4 v[72:75], v37, s[16:19], s14 offen offset:0
    buffer_load_dwordx4 v[76:79], v37, s[16:19], s14 offen offset:32
    buffer_load_dwordx4 v[80:83], v37, s[16:19], s14 offen offset:64
    buffer_load_dwordx4 v[84:87], v37, s[16:19], s14 offen offset:96
K2_XV1:
K2_NOEL:
    v_exp_f32 v44, v244
    v_exp_f32 v45, v245
    v_exp_f32 v46, v246
    v_exp_f32 v47, v247
    v_exp_f32 v48, v248
    v_exp_f32 v49, v249
    v_exp_f32 v50, v250
    v_exp_f32 v51, v251
    v_exp_f32 v52, v252
    v_exp_f32 v53, v253
    v_exp_f32 v54, v254
    v_exp_f32 v55, v255
    v_pk_add_f32 v[40:41], v[40:41], 1.0 op_sel_hi:[1,0]
    v_pk_add_f32 v[42:43], v[42:43], 1.0 op_sel_hi:[1,0]
    v_pk_add_f32 v[44:45], v[44:45], 1.0 op_sel_hi:[1,0]
    v_pk_add_f32 v[46:47], v[46:47], 1.0 op_sel_hi:[1,0]
    v_pk_add_f32 v[48:49], v[48:49], 1.0 op_sel_hi:[1,0]
    v_pk_add_f32 v[50:51], v[50:51], 1.0 op_sel_hi:[1,0]
    v_pk_add_f32 v[52:53], v[52:53], 1.0 op_sel_hi:[1,0]
    v_pk_add_f32 v[54:55], v[54:55], 1.0 op_sel_hi:[1,0]
    v_rcp_f32 v40, v40
    v_rcp_f32 v41, v41
    v_rcp_f32 v42, v42
    v_rcp_f32 v43, v43
    v_rcp_f32 v44, v44
    v_rcp_f32 v45, v45
    s_setprio 0
    v_rcp_f32 v46, v46
    v_rcp_f32 v47, v47
    v_rcp_f32 v48, v48
    v_rcp_f32 v49, v49
    v_rcp_f32 v50, v50
    v_rcp_f32 v51, v51
    v_rcp_f32 v52, v52
    v_rcp_f32 v53, v53
    v_rcp_f32 v54, v54
    v_rcp_f32 v55, v55
    v_pk_mul_f32 v[40:41], v[240:241], v[40:41]
    v_pk_mul_f32 v[42:43], v[242:243], v[42:43]
    v_pk_mul_f32 v[44:45], v[244:245], v[44:45]
    v_pk_mul_f32 v[46:47], v[246:247], v[46:47]
    v_pk_mul_f32 v[48:49], v[248:249], v[48:49]
    v_pk_mul_f32 v[50:51], v[250:251], v[50:51]
    v_pk_mul_f32 v[52:53], v[252:253], v[52:53]
    v_pk_mul_f32 v[54:55], v[254:255], v[54:55]
    v_cvt_pk_bf16_f32 v240, v40, v41
    v_cvt_pk_bf16_f32 v241, v42, v43
    v_cvt_pk_bf16_f32 v242, v44, v45
    v_cvt_pk_bf16_f32 v243, v46, v47
    v_cvt_pk_bf16_f32 v244, v48, v49
    v_cvt_pk_bf16_f32 v245, v50, v51
    v_mfma_f32_32x32x16_bf16 v[208:223], v[240:243], v[56:59], v[208:223]
    v_cvt_pk_bf16_f32 v246, v52, v53
    v_cvt_pk_bf16_f32 v247, v54, v55
    s_nop 1
    v_mfma_f32_32x32x16_bf16 v[208:223], v[244:247], v[60:63], v[208:223]
    s_cmp_eq_u32 s45, 0
    s_cbranch_scc1 K2_EPI
K2_LOOPEND:
    s_cmp_eq_u32 s45, 0
    s_cbranch_scc1 K2_EPI0
    s_waitcnt vmcnt(0) lgkmcnt(0)
    s_barrier
    s_mov_b32 s56, 0
    s_branch K2_ROUND
K2_OVF:
    s_movk_i32 s51, 256
    s_movk_i32 s61, 256
    s_waitcnt vmcnt(0) lgkmcnt(0)
    s_barrier
    s_mov_b32 s56, 0
    s_branch K2_ROUND
K2_EPI0:
    s_waitcnt lgkmcnt(0)
    v_add_u32 v70, 141568, v38
    ds_read_b128 v[128:131], v70 offset:0
    ds_read_b128 v[132:135], v70 offset:1024
    ds_read_b128 v[136:139], v70 offset:2048
    ds_read_b128 v[140:143], v70 offset:3072
    ds_read_b128 v[144:147], v70 offset:4096
    ds_read_b128 v[148:151], v70 offset:5120
    ds_read_b128 v[152:155], v70 offset:6144
    ds_read_b128 v[156:159], v70 offset:7168
    ds_read_b128 v[160:163], v70 offset:8192
    ds_read_b128 v[164:167], v70 offset:9216
    ds_read_b128 v[168:171], v70 offset:10240
    ds_read_b128 v[172:175], v70 offset:11264
    ds_read_b128 v[176:179], v70 offset:12288
    ds_read_b128 v[180:183], v70 offset:13312
    ds_read_b128 v[184:187], v70 offset:14336
    ds_read_b128 v[188:191], v70 offset:15360
    s_cmp_eq_u32 s56, 1
    s_cbranch_scc1 K2_XV2
    buffer_load_dwordx4 v[72:75], v37, s[16:19], s14 offen offset:0
    buffer_load_dwordx4 v[76:79], v37, s[16:19], s14 offen offset:32
    buffer_load_dwordx4 v[80:83], v37, s[16:19], s14 offen offset:64
    buffer_load_dwordx4 v[84:87], v37, s[16:19], s14 offen offset:96
K2_XV2:
K2_EPI:
    s_nop 9
    s_mov_b32 s46, 0xbf317218
    s_mov_b32 s47, 0xbfb8aa3b
    s_mov_b32 s48, s46
    s_mov_b32 s49, s46
    v_pk_mul_f32 v[192:193], v[192:193], s[48:49]
    v_pk_mul_f32 v[194:195], v[194:195], s[48:49]
    v_pk_mul_f32 v[196:197], v[196:197], s[48:49]
    v_pk_mul_f32 v[198:199], v[198:199], s[48:49]
    v_pk_mul_f32 v[200:201], v[200:201], s[48:49]
    v_pk_mul_f32 v[202:203], v[202:203], s[48:49]
    v_pk_mul_f32 v[204:205], v[204:205], s[48:49]
    v_pk_mul_f32 v[206:207], v[206:207], s[48:49]
    v_pk_mul_f32 v[208:209], v[208:209], s[48:49]
    v_pk_mul_f32 v[210:211], v[210:211], s[48:49]
    v_pk_mul_f32 v[212:213], v[212:213], s[48:49]
    v_pk_mul_f32 v[214:215], v[214:215], s[48:49]
    v_pk_mul_f32 v[216:217], v[216:217], s[48:49]
    v_pk_mul_f32 v[218:219], v[218:219], s[48:49]
    v_pk_mul_f32 v[220:221], v[220:221], s[48:49]
    v_pk_mul_f32 v[222:223], v[222:223], s[48:49]
    s_mov_b32 s48, s47
    s_mov_b32 s49, s47
    v_cvt_pk_bf16_f32 v192, v192, v193
    v_cvt_pk_bf16_f32 v193, v194, v195
    v_cvt_pk_bf16_f32 v194, v196, v197
    v_cvt_pk_bf16_f32 v195, v198, v199
    v_cvt_pk_bf16_f32 v196, v200, v201
    v_cvt_pk_bf16_f32 v197, v202, v203
    v_cvt_pk_bf16_f32 v198, v204, v205
    v_cvt_pk_bf16_f32 v199, v206, v207
    v_cvt_pk_bf16_f32 v200, v208, v209
    v_cvt_pk_bf16_f32 v201, v210, v211
    v_cvt_pk_bf16_f32 v202, v212, v213
    v_cvt_pk_bf16_f32 v203, v214, v215
    v_cvt_pk_bf16_f32 v204, v216, v217
    v_cvt_pk_bf16_f32 v205, v218, v219
    v_cvt_pk_bf16_f32 v206, v220, v221
    v_cvt_pk_bf16_f32 v207, v222, v223
    v_cmp_gt_u32 vcc, 25, v35
    v_lshlrev_b32 v2, 7, v35
    v_lshl_add_u32 v2, v36, 6, v2
    v_mov_b32 v3, 0x7ffffff0
    v_cndmask_b32 v2, v3, v2, vcc
    v_and_b32 v9, 7, v35
    v_lshlrev_b32 v10, 2, v36
    v_xor_b32 v9, v9, v10
    v_lshlrev_b32 v9, 4, v9
    v_lshlrev_b32 v10, 7, v35
    v_add_u32 v10, s44, v10
    v_xor_b32 v4, 0, v9
    v_add_u32 v4, v4, v10
    v_xor_b32 v5, 16, v9
    v_add_u32 v5, v5, v10
    v_xor_b32 v6, 32, v9
    v_add_u32 v6, v6, v10
    v_xor_b32 v7, 48, v9
    v_add_u32 v7, v7, v10
    v_lshrrev_b32 v8, 3, v1
    v_xor_b32 v8, v8, v1
    v_and_b32 v8, 7, v8
    v_lshlrev_b32 v8, 4, v8
    v_and_b32 v9, 0x380, v38
    v_add3_u32 v8, v8, v9, s44
    v_cmp_gt_u32 vcc, 8, v1
    s_nop 1
    v_cndmask_b32 v10, v3, v38, vcc
    s_waitcnt vmcnt(0) lgkmcnt(0)
    v_mfma_f32_32x32x16_bf16 v[224:239], v[128:131], v[72:75], 0
    v_mfma_f32_32x32x16_bf16 v[224:239], v[136:139], v[76:79], v[224:239]
    v_mfma_f32_32x32x16_bf16 v[224:239], v[144:147], v[80:83], v[224:239]
    v_mfma_f32_32x32x16_bf16 v[224:239], v[152:155], v[84:87], v[224:239]
    v_mfma_f32_32x32x16_bf16 v[224:239], v[160:163], v[192:195], v[224:239]
    v_mfma_f32_32x32x16_bf16 v[224:239], v[168:171], v[196:199], v[224:239]
    v_mfma_f32_32x32x16_bf16 v[224:239], v[176:179], v[200:203], v[224:239]
    v_mfma_f32_32x32x16_bf16 v[224:239], v[184:187], v[204:207], v[224:239]
    v_mfma_f32_32x32x16_bf16 v[240:255], v[132:135], v[72:75], 0
    v_mfma_f32_32x32x16_bf16 v[240:255], v[140:143], v[76:79], v[240:255]
    v_mfma_f32_32x32x16_bf16 v[240:255], v[148:151], v[80:83], v[240:255]
    v_mfma_f32_32x32x16_bf16 v[240:255], v[156:159], v[84:87], v[240:255]
    v_mfma_f32_32x32x16_bf16 v[240:255], v[164:167], v[192:195], v[240:255]
    v_mfma_f32_32x32x16_bf16 v[240:255], v[172:175], v[196:199], v[240:255]
    v_mfma_f32_32x32x16_bf16 v[240:255], v[180:183], v[200:203], v[240:255]
    v_mfma_f32_32x32x16_bf16 v[240:255], v[188:191], v[204:207], v[240:255]
    s_nop 11
    v_pk_mul_f32 v[64:65], v[224:225], s[48:49]
    v_pk_mul_f32 v[66:67], v[226:227], s[48:49]
    v_pk_mul_f32 v[68:69], v[228:229], s[48:49]
    v_pk_mul_f32 v[70:71], v[230:231], s[48:49]
    v_pk_mul_f32 v[72:73], v[232:233], s[48:49]
    v_pk_mul_f32 v[74:75], v[234:235], s[48:49]
    v_pk_mul_f32 v[76:77], v[236:237], s[48:49]
    v_pk_mul_f32 v[78:79], v[238:239], s[48:49]
    v_exp_f32 v64, v64
    v_exp_f32 v65, v65
    v_exp_f32 v66, v66
    v_exp_f32 v67, v67
    v_exp_f32 v68, v68
    v_exp_f32 v69, v69
    v_exp_f32 v70, v70
    v_exp_f32 v71, v71
    v_exp_f32 v72, v72
    v_exp_f32 v73, v73
    v_exp_f32 v74, v74
    v_exp_f32 v75, v75
    v_exp_f32 v76, v76
    v_exp_f32 v77, v77
    v_exp_f32 v78, v78
    v_exp_f32 v79, v79
    v_pk_add_f32 v[64:65], v[64:65], 1.0 op_sel_hi:[1,0]
    v_pk_add_f32 v[66:67], v[66:67], 1.0 op_sel_hi:[1,0]
    v_pk_add_f32 v[68:69], v[68:69], 1.0 op_sel_hi:[1,0]
    v_pk_add_f32 v[70:71], v[70:71], 1.0 op_sel_hi:[1,0]
    v_pk_add_f32 v[72:73], v[72:73], 1.0 op_sel_hi:[1,0]
    v_pk_add_f32 v[74:75], v[74:75], 1.0 op_sel_hi:[1,0]
    v_pk_add_f32 v[76:77], v[76:77], 1.0 op_sel_hi:[1,0]
    v_pk_add_f32 v[78:79], v[78:79], 1.0 op_sel_hi:[1,0]
    v_rcp_f32 v64, v64
    v_rcp_f32 v65, v65
    v_rcp_f32 v66, v66
    v_rcp_f32 v67, v67
    v_rcp_f32 v68, v68
    v_rcp_f32 v69, v69
    v_rcp_f32 v70, v70
    v_rcp_f32 v71, v71
    v_rcp_f32 v72, v72
    v_rcp_f32 v73, v73
    v_rcp_f32 v74, v74
    v_rcp_f32 v75, v75
    v_rcp_f32 v76, v76
    v_rcp_f32 v77, v77
    v_rcp_f32 v78, v78
    v_rcp_f32 v79, v79
    v_pk_mul_f32 v[64:65], v[224:225], v[64:65]
    v_pk_mul_f32 v[66:67], v[226:227], v[66:67]
    v_pk_mul_f32 v[68:69], v[228:229], v[68:69]
    v_pk_mul_f32 v[70:71], v[230:231], v[70:71]
    v_pk_mul_f32 v[72:73], v[232:233], v[72:73]
    v_pk_mul_f32 v[74:75], v[234:235], v[74:75]
    v_pk_mul_f32 v[76:77], v[236:237], v[76:77]
    v_pk_mul_f32 v[78:79], v[238:239], v[78:79]
    v_cvt_pk_bf16_f32 v80, v64, v65
    v_cvt_pk_bf16_f32 v81, v66, v67
    v_cvt_pk_bf16_f32 v82, v68, v69
    v_cvt_pk_bf16_f32 v83, v70, v71
    v_cvt_pk_bf16_f32 v84, v72, v73
    v_cvt_pk_bf16_f32 v85, v74, v75
    v_cvt_pk_bf16_f32 v86, v76, v77
    v_cvt_pk_bf16_f32 v87, v78, v79
    ds_write_b128 v4, v[80:83]
    ds_write_b128 v5, v[84:87]
    v_pk_mul_f32 v[64:65], v[240:241], s[48:49]
    v_pk_mul_f32 v[66:67], v[242:243], s[48:49]
    v_pk_mul_f32 v[68:69], v[244:245], s[48:49]
    v_pk_mul_f32 v[70:71], v[246:247], s[48:49]
    v_pk_mul_f32 v[72:73], v[248:249], s[48:49]
    v_pk_mul_f32 v[74:75], v[250:251], s[48:49]
    v_pk_mul_f32 v[76:77], v[252:253], s[48:49]
    v_pk_mul_f32 v[78:79], v[254:255], s[48:49]
    v_exp_f32 v64, v64
    v_exp_f32 v65, v65
    v_exp_f32 v66, v66
    v_exp_f32 v67, v67
    v_exp_f32 v68, v68
    v_exp_f32 v69, v69
    v_exp_f32 v70, v70
    v_exp_f32 v71, v71
    v_exp_f32 v72, v72
    v_exp_f32 v73, v73
    v_exp_f32 v74, v74
    v_exp_f32 v75, v75
    v_exp_f32 v76, v76
    v_exp_f32 v77, v77
    v_exp_f32 v78, v78
    v_exp_f32 v79, v79
    v_pk_add_f32 v[64:65], v[64:65], 1.0 op_sel_hi:[1,0]
    v_pk_add_f32 v[66:67], v[66:67], 1.0 op_sel_hi:[1,0]
    v_pk_add_f32 v[68:69], v[68:69], 1.0 op_sel_hi:[1,0]
    v_pk_add_f32 v[70:71], v[70:71], 1.0 op_sel_hi:[1,0]
    v_pk_add_f32 v[72:73], v[72:73], 1.0 op_sel_hi:[1,0]
    v_pk_add_f32 v[74:75], v[74:75], 1.0 op_sel_hi:[1,0]
    v_pk_add_f32 v[76:77], v[76:77], 1.0 op_sel_hi:[1,0]
    v_pk_add_f32 v[78:79], v[78:79], 1.0 op_sel_hi:[1,0]
    v_rcp_f32 v64, v64
    v_rcp_f32 v65, v65
    v_rcp_f32 v66, v66
    v_rcp_f32 v67, v67
    v_rcp_f32 v68, v68
    v_rcp_f32 v69, v69
    v_rcp_f32 v70, v70
    v_rcp_f32 v71, v71
    v_rcp_f32 v72, v72
    v_rcp_f32 v73, v73
    v_rcp_f32 v74, v74
    v_rcp_f32 v75, v75
    v_rcp_f32 v76, v76
    v_rcp_f32 v77, v77
    v_rcp_f32 v78, v78
    v_rcp_f32 v79, v79
    v_pk_mul_f32 v[64:65], v[240:241], v[64:65]
    v_pk_mul_f32 v[66:67], v[242:243], v[66:67]
    v_pk_mul_f32 v[68:69], v[244:245], v[68:69]
    v_pk_mul_f32 v[70:71], v[246:247], v[70:71]
    v_pk_mul_f32 v[72:73], v[248:249], v[72:73]
    v_pk_mul_f32 v[74:75], v[250:251], v[74:75]
    v_pk_mul_f32 v[76:77], v[252:253], v[76:77]
    v_pk_mul_f32 v[78:79], v[254:255], v[78:79]
    v_cvt_pk_bf16_f32 v88, v64, v65
    v_cvt_pk_bf16_f32 v89, v66, v67
    v_cvt_pk_bf16_f32 v90, v68, v69
    v_cvt_pk_bf16_f32 v91, v70, v71
    v_cvt_pk_bf16_f32 v92, v72, v73
    v_cvt_pk_bf16_f32 v93, v74, v75
    v_cvt_pk_bf16_f32 v94, v76, v77
    v_cvt_pk_bf16_f32 v95, v78, v79
    ds_write_b128 v6, v[88:91]
    ds_write_b128 v7, v[92:95]
    ds_read_b128 v[96:99], v8 offset:0
    ds_read_b128 v[100:103], v8 offset:1024
    ds_read_b128 v[104:107], v8 offset:2048
    ds_read_b128 v[108:111], v8 offset:3072
    s_waitcnt lgkmcnt(3)
    buffer_store_dwordx4 v[96:99], v38, s[20:23], s14 offen offset:0 nt
    s_waitcnt lgkmcnt(2)
    buffer_store_dwordx4 v[100:103], v38, s[20:23], s14 offen offset:1024 nt
    s_waitcnt lgkmcnt(1)
    buffer_store_dwordx4 v[104:107], v38, s[20:23], s14 offen offset:2048 nt
    s_waitcnt lgkmcnt(0)
    buffer_store_dwordx4 v[108:111], v10, s[20:23], s14 offen offset:3072 nt
K2_END:
    s_endpgm
.section .rodata,"a"
.p2align 6
.amdhsa_kernel k1_kernel
  .amdhsa_next_free_vgpr 64
  .amdhsa_next_free_sgpr 102
  .amdhsa_accum_offset 64
  .amdhsa_group_segment_fixed_size 0
  .amdhsa_kernarg_size 72
  .amdhsa_user_sgpr_count 2
  .amdhsa_user_sgpr_kernarg_segment_ptr 1
  .amdhsa_system_sgpr_workgroup_id_x 1
.end_amdhsa_kernel
.p2align 6
.amdhsa_kernel k2_kernel
  .amdhsa_next_free_vgpr 256
  .amdhsa_next_free_sgpr 102
  .amdhsa_accum_offset 256
  .amdhsa_group_segment_fixed_size 0
  .amdhsa_kernarg_size 72
  .amdhsa_user_sgpr_count 2
  .amdhsa_user_sgpr_kernarg_segment_ptr 1
  .amdhsa_system_sgpr_workgroup_id_x 1
.end_amdhsa_kernel
```
